```python
import torch

def _softmax(x, axis=-1):
    return torch.softmax(x, dim=axis)
def _gelu(x):
    return torch.nn.functional.gelu(x, approximate="tanh")
def _silu(x):
    return torch.nn.functional.silu(x)
def _sigmoid(x):
    return torch.sigmoid(x)
def _layernorm(x, axis=-1, eps=1e-5):
    m = x.mean(dim=axis, keepdim=True)
    v = x.var(dim=axis, keepdim=True, unbiased=False)
    return (x - m) / torch.sqrt(v + eps)
def _scatter_add(tgt, idx, src, axis=0):
    return tgt.clone().index_add_(axis, idx, src)
def _segment_sum(src, seg, n):
    out = torch.zeros((n,) + src.shape[1:], dtype=src.dtype)
    return out.index_add_(0, seg, src)
def _pad(x, pw):
    flat = tuple(v for pair in reversed(pw) for v in pair)
    return torch.nn.functional.pad(x, flat)

kernel_name = 'standalone__paged_block_table_kv_radixattention__decode'

def setup_inputs():

    _w = (lambda a: (lambda t: t.to(torch.bfloat16) if t.is_floating_point() else t)(torch.as_tensor(a)))
    B, H, Hkv, Dh = 2, 32, 8, 128
    Lk = 32768
    bs = 16
    nb = max(2, Lk // bs)
    P = max(1, nb // 2)
    n_phys = P + B * (nb - P)
    shared = torch.arange(P, dtype=torch.int64)
    priv = P + torch.arange(B * (nb - P), dtype=torch.int64).reshape(B, nb - P)
    bt = torch.cat([torch.tile(shared[None, :], (B, 1)), priv], dim=1)
    ctx = nb * bs - (torch.arange(1, B + 1, dtype=torch.int64) * 2654435761) % max(1, (nb * bs - P * bs) // 2)
    return {
        "q": _w((lambda *s: torch.randn(*s, dtype=torch.bfloat16) * 0.8)(B, H, Dh)),
        "k_cache": _w((lambda *s: torch.randn(*s, dtype=torch.bfloat16) * 0.8)(n_phys, bs, Hkv, Dh)),
        "v_cache": _w((lambda *s: torch.randn(*s, dtype=torch.bfloat16) * 0.05)(n_phys, bs, Hkv, Dh)),
        "block_table": _w(bt.to(torch.int64)),
        "ctx_lens": _w(torch.as_tensor(ctx).to(torch.int64)),
    }

def reference(q, k_cache, v_cache, block_table, ctx_lens):
    B, H, Dh = q.shape
    n_phys, bs, Hkv, _ = k_cache.shape
    nb = block_table.shape[1]
    Lk = nb * bs
    rep = H // Hkv
    k = k_cache[block_table].reshape(B, Lk, Hkv, Dh)
    v = v_cache[block_table].reshape(B, Lk, Hkv, Dh)
    k = (lambda x, n, axis: torch.repeat_interleave(x, n, dim=axis))(k, rep, axis=2)
    v = (lambda x, n, axis: torch.repeat_interleave(x, n, dim=axis))(v, rep, axis=2)
    scores = torch.einsum("bhd,bkhd->bhk", q, k) * (Dh ** -0.5)
    pos = torch.arange(Lk)
    valid = pos[None, :] < ctx_lens[:, None]
    scores = torch.where(valid[:, None, :], scores, -1e9)
    p = _softmax(scores, axis=-1)
    return torch.einsum("bhk,bkhd->bhd", p, v)
```

```asm
; @launch grid=(256,1,1) block=(320,1,1) lds=18452
.amdgcn_target "amdgcn-amd-amdhsa--gfx950"
.text
.globl standalone__paged_block_table_kv_radixattention__decode_kernel
.p2align 12
.p2align 8
.type standalone__paged_block_table_kv_radixattention__decode_kernel,@function
standalone__paged_block_table_kv_radixattention__decode_kernel:
    s_cmp_ge_u32 s2, 256
    s_cbranch_scc1 L_end
    s_load_dwordx2 s[20:21], s[0:1], 24
    s_getpc_b64 s[52:53]
L_pc:
    v_lshlrev_b32 v18, 6, v0
    v_min_u32 v18, L_end-L_pc, v18
    global_load_dword v114, v18, s[52:53]
    s_load_dwordx2 s[16:17], s[0:1], 0
    s_load_dwordx2 s[8:9], s[0:1], 8
    s_load_dwordx2 s[12:13], s[0:1], 16
    s_load_dwordx2 s[28:29], s[0:1], 32
    s_load_dwordx2 s[24:25], s[0:1], 56
    s_load_dwordx2 s[64:65], s[0:1], 40
    s_and_b32 s43, s2, 7
    s_bfe_u32 s44, s2, 0x30003
    s_and_b32 s2, s2, 0xc0
    s_lshl3_add_u32 s2, s43, s2
    s_add_u32 s2, s2, s44
    v_lshrrev_b32 v18, 6, v0
    v_and_b32 v0, 63, v0
    v_readfirstlane_b32 s34, v18
    s_bfe_u32 s32, s2, 0x30003
    s_lshr_b32 s60, s2, 6
    s_lshl_b32 s33, s60, 3
    s_and_b32 s43, s2, 7
    s_add_u32 s33, s33, s43
    s_mov_b32 s22, 16384
    s_mov_b32 s23, 0x20000
    s_mov_b32 s26, 3145728
    s_mov_b32 s27, 0x20000
    s_cmp_eq_u32 s34, 4
    s_cbranch_scc1 L_service
    s_lshl_b32 s35, s34, 5
    s_add_u32 s35, s35, s33
    s_mov_b32 s18, 16384
    s_mov_b32 s19, 0x20000
    s_mov_b32 s10, 100663296
    s_mov_b32 s11, 0x20000
    s_mov_b32 s14, 100663296
    s_mov_b32 s15, 0x20000
    v_and_b32 v56, 1, v0
    v_lshrrev_b32 v57, 1, v0
    v_lshlrev_b32 v58, 13, v56
    v_lshl_add_u32 v58, v57, 9, v58
    s_lshl_b32 s43, s35, 2
    v_and_b32 v18, 15, v0
    v_lshrrev_b32 v19, 4, v0
    v_lshrrev_b32 v20, 2, v18
    v_and_b32 v21, 3, v0
    v_lshlrev_b32 v22, 6, v19
    v_lshl_add_u32 v22, v21, 4, v22
    v_lshl_add_u32 v60, v20, 8, v22
    s_lshl_b32 s44, s32, 8
    s_lshl_b32 s56, s32, 10
    s_add_u32 s57, s56, 8192
    v_lshl_add_u32 v1, v20, 13, v22
    v_add_u32 v1, s44, v1
    v_add_u32 v2, 4096, v1
    v_lshlrev_b32 v3, 13, v19
    v_lshl_add_u32 v3, v18, 4, v3
    v_add_u32 v3, s44, v3
    v_add_u32 v4, 4096, v3
    s_lshl_b32 s39, s35, 15
    s_mov_b32 s45, 100663296
    s_mov_b32 s69, 0
    s_mov_b32 s68, 0
    s_waitcnt lgkmcnt(0)
    buffer_load_dword v61, v58, s[20:23], s43 offen
    s_load_dwordx2 s[30:31], s[28:29], 0
    buffer_load_dwordx4 v[24:27], v60, s[16:19], s56 offen
    buffer_load_dwordx4 v[28:31], v60, s[16:19], s57 offen
    buffer_load_dwordx4 v[80:83], v1, s[8:11], s39 offen offset:0 nt
    buffer_load_dwordx4 v[84:87], v1, s[8:11], s39 offen offset:2048 nt
    buffer_load_dwordx4 v[88:91], v2, s[8:11], s39 offen offset:0 nt
    buffer_load_dwordx4 v[92:95], v2, s[8:11], s39 offen offset:2048 nt
    buffer_load_dwordx4 v[96:99], v3, s[12:15], s39 offen offset:0 nt
    buffer_load_dwordx4 v[100:103], v3, s[12:15], s39 offen offset:2048 nt
    buffer_load_dwordx4 v[104:107], v4, s[12:15], s39 offen offset:0 nt
    v_lshl_add_u32 v10, v19, 2, 0
    v_lshl_add_u32 v11, v19, 2, 1
    v_lshl_add_u32 v12, v19, 2, 2
    v_lshl_add_u32 v13, v19, 2, 3
    v_mov_b32 v8, 0x3e0293ee
    v_mov_b32 v9, 0xff800000
    v_mov_b32 v112, 4096
    v_mov_b32 v113, 0
    s_mov_b32 s77, 0
    s_getreg_b32 s43, hwreg(HW_REG_XCC_ID, 0, 3)
    s_mov_b32 s3, 0x8880aa00
    s_bitcmp1_b32 0xf1, s43
    s_cmov_b32 s3, 0xaaa8ee88
    s_lshl_b32 s43, s32, 3
    s_lshr_b32 s3, s3, s43
    v_and_b32 v22, 1, v21
    v_lshlrev_b32 v22, 4, v22
    v_mov_b32 v23, 0xffff
    v_lshlrev_b32 v23, v22, v23
    v_cmp_gt_u32 vcc, 2, v21
    s_lshl_b32 s43, s35, 4
    v_lshlrev_b32 v59, 11, v57
    v_cndmask_b32 v5, 0, v23, vcc
    v_xor_b32 v6, v5, v23
    v_add_u32 v59, s43, v59
    v_mov_b32 v32, 0
    v_mov_b32 v33, 0
    v_mov_b32 v34, 0
    v_mov_b32 v35, 0
    v_mov_b32 v36, 0
    v_mov_b32 v37, 0
    v_mov_b32 v38, 0
    v_mov_b32 v39, 0
    v_mov_b32 v14, 0
    v_mov_b32 v15, 0
    s_mov_b32 s48, 0xff800000
    s_mov_b32 s50, 0xff800000
    v_mov_b32 v40, 0
    v_mov_b32 v41, 0
    v_mov_b32 v42, 0
    v_mov_b32 v43, 0
    v_mov_b32 v44, 0
    v_mov_b32 v45, 0
    v_mov_b32 v46, 0
    v_mov_b32 v47, 0
    v_mov_b32 v16, 0
    v_mov_b32 v17, 0
    s_mov_b32 s49, 0xff800000
    s_mov_b32 s51, 0xff800000
    s_lshl_b32 s43, s34, 3
    v_add_u32 v18, s43, v20
    v_lshlrev_b32 v115, 1, v19
    v_xor_b32 v115, v115, v20
    v_lshl_add_u32 v115, v18, 3, v115
    v_lshl_add_u32 v115, v115, 2, v21
    v_lshlrev_b32 v115, 4, v115
    v_xor_b32 v116, 64, v115
    v_lshrrev_b32 v18, 5, v0
    v_lshl_add_u32 v22, v18, 2, v20
    v_lshl_add_u32 v117, v22, 5, s43
    s_lshl_b32 s43, s34, 1
    v_add_u32 v18, s43, v18
    v_lshlrev_b32 v118, 5, v18
    v_and_b32 v22, 31, v0
    v_and_b32 v119, 3, v18
    v_lshlrev_b32 v119, 2, v119
    v_xor_b32 v119, v119, v22
    v_lshl_add_u32 v119, v18, 5, v119
    v_lshlrev_b32 v119, 4, v119
    v_lshrrev_b32 v23, 3, v22
    v_lshl_add_u32 v23, v18, 2, v23
    v_and_b32 v22, 7, v22
    v_lshlrev_b32 v120, 12, v23
    v_and_b32 v124, 15, v23
    v_lshl_add_u32 v124, v124, 7, v120
    v_lshl_add_u32 v120, v22, 3, v120
    v_and_b32 v22, 1, v0
    s_lshl_b32 s43, s34, 4
    v_lshl_add_u32 v121, v57, 6, s43
    v_lshl_add_u32 v121, v22, 3, v121
    s_and_b32 s43, s33, 15
    s_lshl_b32 s43, s43, 7
    s_add_u32 s43, s43, 2048
    v_lshl_add_u32 v125, v57, 2, s43
    v_lshlrev_b32 v122, 4, v19
    v_lshl_add_u32 v122, v22, 1, v122
    s_lshl_b32 s75, s32, 5
    s_add_u32 s75, s75, s33
    s_lshl_b32 s75, s75, 12
    s_lshr_b32 s76, s33, 4
    s_lshl_b32 s76, s76, 13
    s_add_u32 s76, s76, s56
    s_and_b32 s43, s33, 15
    s_lshl4_add_u32 s43, s43, s34
    s_lshl2_add_u32 s76, s43, s76
    s_lshr_b32 s43, s33, 2
    s_lshl_b32 s43, s43, 5
    v_mov_b32 v123, s43
    s_mov_b32 s66, 16384
    s_mov_b32 s67, 0x20000
    s_lshl_b32 s74, s32, 17
    s_lshl2_add_u32 s70, s33, s74
    s_lshl_b32 s43, s33, 6
    s_add_u32 s74, s74, s43
    v_cmp_eq_u32 vcc, 1, v56
    s_add_u32 s60, s60, s34
    s_and_b32 s60, s60, 3
    s_lshl_b32 s61, s60, 3
    s_bfe_u32 s43, s2, 0x30003
    s_add_u32 s61, s61, s43
    s_lshl_b32 s60, s60, 2
    s_lshl_b32 s61, s61, 8
    s_add_u32 s61, s61, 0x200000
    v_cndmask_b32 v126, v121, v125, vcc
    s_barrier
    s_waitcnt lgkmcnt(0)
    s_cmp_lt_i32 s30, 1
    s_cselect_b32 s46, 1, 0
    s_cselect_b32 s30, 0x8000, s30
    s_min_u32 s30, s30, 0x8000
    s_cmp_lt_i32 s31, 1
    s_cselect_b32 s47, 1, 0
    s_cselect_b32 s31, 0x8000, s31
    s_min_u32 s31, s31, 0x8000
    s_and_b32 s62, s30, 0xf800
    s_and_b32 s63, s31, 0xf800
    s_add_u32 s43, s30, s31
    s_sub_u32 s43, s43, s62
    s_sub_u32 s43, s43, s63
    s_cmp_lt_u32 s43, 2048
    s_cselect_b32 s43, 2048, 0
    s_cmp_lt_u32 s62, s63
    s_cselect_b32 s44, 0, s43
    s_cselect_b32 s43, s43, 0
    s_sub_i32 s62, s62, s44
    s_sub_i32 s63, s63, s43
    s_max_i32 s43, s62, s63
    s_cmp_lt_i32 s43, 4096
    s_cselect_b32 s62, 0x8000, s62
    s_cselect_b32 s63, 0x8000, s63
    s_min_u32 s30, s30, s62
    s_min_u32 s31, s31, s63
    v_mov_b32 v18, s30
    v_mov_b32 v20, s31
    v_cndmask_b32 v22, v18, v20, vcc
    v_cndmask_b32 v20, v20, v18, vcc
    v_sub_u32 v22, v22, v59
    v_sub_u32 v20, v20, v59
    v_med3_i32 v22, v22, 0, 16
    v_med3_i32 v20, v20, 0, 16
    v_lshlrev_b32 v18, 5, v22
    v_lshl_or_b32 v20, v20, 5, v22
    v_cndmask_b32 v22, v22, v18, vcc
    v_cndmask_b32 v20, v20, v113, vcc
    v_cmp_gt_u32 s[58:59], 32, v0
    s_waitcnt vmcnt(9)
    v_min_u32 v61, 3071, v61
    s_nop 1
    v_mov_b32_dpp v23, v61 quad_perm:[1,0,3,2] row_mask:0xf bank_mask:0xf
    v_cmp_eq_u32 vcc, v23, v61
    s_nop 1
    v_cndmask_b32 v20, v22, v20, vcc
    v_cndmask_b32 v20, v113, v20, s[58:59]
    v_cmp_ne_u32 vcc, 0, v20
    v_lshl_or_b32 v7, v61, 15, v20
    s_mov_b32 s43, s39
    s_mov_b32 s36, vcc_lo
    s_ff1_i32_b32 s37, s36
    s_bitset0_b32 s36, s37
    v_readlane_b32 s38, v7, s37
    s_and_b32 s39, s38, 0xffff8000
    s_and_b32 s42, s38, 0x3ff
    s_cselect_b32 s10, s45, 0
    s_cselect_b32 s14, s45, 0
    s_cbranch_scc0 L_none
    s_cmp_eq_u32 s43, s39
    s_cbranch_scc1 L_spec_ok
    s_waitcnt vmcnt(0)
    buffer_load_dwordx4 v[80:83], v1, s[8:11], s39 offen offset:0 nt
    buffer_load_dwordx4 v[84:87], v1, s[8:11], s39 offen offset:2048 nt
    buffer_load_dwordx4 v[88:91], v2, s[8:11], s39 offen offset:0 nt
    buffer_load_dwordx4 v[92:95], v2, s[8:11], s39 offen offset:2048 nt
    buffer_load_dwordx4 v[96:99], v3, s[12:15], s39 offen offset:0 nt
    buffer_load_dwordx4 v[100:103], v3, s[12:15], s39 offen offset:2048 nt
    buffer_load_dwordx4 v[104:107], v4, s[12:15], s39 offen offset:0 nt
L_spec_ok:
    s_or_b32 s43, s46, s47
    s_cbranch_scc0 L_go
    s_waitcnt vmcnt(7)
    s_cmp_eq_u32 s46, 0
    s_cbranch_scc1 L_noz0
    v_mov_b32 v24, 0
    v_mov_b32 v25, 0
    v_mov_b32 v26, 0
    v_mov_b32 v27, 0
L_noz0:
    s_cmp_eq_u32 s47, 0
    s_cbranch_scc1 L_noz1
    v_mov_b32 v28, 0
    v_mov_b32 v29, 0
    v_mov_b32 v30, 0
    v_mov_b32 v31, 0
L_noz1:
L_go:
    s_waitcnt vmcnt(4)
    s_branch L_body
L_slow0:
    v_mov_b32 v19, v18
    s_nop 1
    v_permlane32_swap_b32 v18, v19
    s_nop 1
    v_max_f32 v18, v18, v19
    v_mov_b32 v19, v18
    s_nop 1
    v_permlane16_swap_b32 v18, v19
    s_nop 1
    v_max3_f32 v18, v18, v19, s50
    v_max_f32 v19, 0, v18
    v_exp_f32 v19, -v19
    v_sub_f32 v14, v14, v18
    v_sub_f32 v56, v56, v18
    v_sub_f32 v57, v57, v18
    v_sub_f32 v58, v58, v18
    v_sub_f32 v59, v59, v18
    v_mul_f32 v32, v19, v32
    v_mul_f32 v33, v19, v33
    v_mul_f32 v34, v19, v34
    v_mul_f32 v35, v19, v35
    v_mul_f32 v36, v19, v36
    v_mul_f32 v37, v19, v37
    v_mul_f32 v38, v19, v38
    v_mul_f32 v39, v19, v39
    v_mul_f32 v15, v19, v15
    s_mov_b32 s48, 0x41000000
    s_mov_b32 s50, 0
    s_branch L_back0
L_slow1:
    v_mov_b32 v19, v18
    s_nop 1
    v_permlane32_swap_b32 v18, v19
    s_nop 1
    v_max_f32 v18, v18, v19
    v_mov_b32 v19, v18
    s_nop 1
    v_permlane16_swap_b32 v18, v19
    s_nop 1
    v_max3_f32 v18, v18, v19, s51
    v_max_f32 v19, 0, v18
    v_exp_f32 v19, -v19
    v_sub_f32 v16, v16, v18
    v_sub_f32 v60, v60, v18
    v_sub_f32 v61, v61, v18
    v_sub_f32 v62, v62, v18
    v_sub_f32 v63, v63, v18
    v_mul_f32 v40, v19, v40
    v_mul_f32 v41, v19, v41
    v_mul_f32 v42, v19, v42
    v_mul_f32 v43, v19, v43
    v_mul_f32 v44, v19, v44
    v_mul_f32 v45, v19, v45
    v_mul_f32 v46, v19, v46
    v_mul_f32 v47, v19, v47
    v_mul_f32 v17, v19, v17
    s_mov_b32 s49, 0x41000000
    s_mov_b32 s51, 0
    s_branch L_back1
L_dyn:
    v_min_u32 v18, 80, v112
    v_lshl_add_u32 v18, v18, 4, s60
    ds_read_b32 v18, v18 offset:17152
    s_waitcnt lgkmcnt(0)
    v_readfirstlane_b32 s38, v18
    s_and_b32 s39, s38, 0xffff8000
    s_and_b32 s42, s38, 0x3ff
    s_cselect_b32 s10, s45, 0
    s_cselect_b32 s14, s45, 0
    s_cselect_b32 s68, 1, 0
    s_branch L_picked
L_first:
    ds_read_b32 v18, v113 offset:18448
    s_mov_b32 s69, 1
    s_waitcnt lgkmcnt(0)
    v_readfirstlane_b32 s68, v18
    v_readfirstlane_b32 s77, v18
    s_cmp_lg_u32 s68, 0
    s_cbranch_scc1 L_picked
    s_sleep 2
    s_branch L_first
L_ticket:
    s_cmp_eq_u32 s68, 0
    s_cbranch_scc1 L_tick_null
    v_mov_b32 v112, 1
    s_mov_b64 exec, 1
    buffer_atomic_add v112, v113, s[24:27], s61 offen sc0 sc1
    s_mov_b64 exec, -1
    s_cmp_eq_u32 s2, s2
    s_branch L_tick_done
L_tick_null:
    buffer_load_dword v114, v126, s[24:27], s75 offen sc1
    s_branch L_tick_done
L_body:
    s_and_b32 s40, s42, 31
    s_lshr_b32 s41, s42, 5
    s_cmp_lg_u32 s69, 0
    s_waitcnt vmcnt(5)
    s_cbranch_scc1 L_w0
    s_waitcnt vmcnt(4)
L_w0:
    buffer_load_dwordx4 v[108:111], v4, s[12:15], s39 offen offset:2048 nt
    s_cmp_eq_u32 s36, 0
    s_cbranch_scc1 L_dyn
    s_ff1_i32_b32 s37, s36
    s_bitset0_b32 s36, s37
    v_readlane_b32 s38, v7, s37
    s_and_b32 s39, s38, 0xffff8000
    s_and_b32 s42, s38, 0x3ff
    s_cselect_b32 s10, s45, 0
    s_cselect_b32 s14, s45, 0
    s_bcnt1_i32_b32 s44, s36
    s_cbranch_scc0 L_first
L_picked:
    s_cmp_lg_u32 s69, 0
    v_mfma_f32_16x16x32_bf16 v[48:51], v[80:83], v[24:27], 0
    v_mfma_f32_16x16x32_bf16 v[52:55], v[80:83], v[28:31], 0
    v_mov_b32 v56, v14
    v_mov_b32 v60, v16
    v_cmp_gt_u32 s[52:53], s40, v10
    v_cmp_gt_u32 s[54:55], s41, v10
    s_nop 2
    v_fmac_f32_dpp v56, v48, v8 quad_perm:[0,0,0,0] row_mask:0xf bank_mask:0xf
    v_fmac_f32_dpp v60, v52, v8 quad_perm:[0,0,0,0] row_mask:0xf bank_mask:0xf
    s_nop 0
    v_fmac_f32_dpp v56, v49, v8 quad_perm:[1,1,1,1] row_mask:0xf bank_mask:0xf
    v_fmac_f32_dpp v60, v53, v8 quad_perm:[1,1,1,1] row_mask:0xf bank_mask:0xf
    s_nop 0
    v_fmac_f32_dpp v56, v50, v8 quad_perm:[2,2,2,2] row_mask:0xf bank_mask:0xf
    v_fmac_f32_dpp v60, v54, v8 quad_perm:[2,2,2,2] row_mask:0xf bank_mask:0xf
    s_nop 0
    v_fmac_f32_dpp v56, v51, v8 quad_perm:[3,3,3,3] row_mask:0xf bank_mask:0xf
    v_fmac_f32_dpp v60, v55, v8 quad_perm:[3,3,3,3] row_mask:0xf bank_mask:0xf
    v_cndmask_b32 v56, v9, v56, s[52:53]
    v_cndmask_b32 v60, v9, v60, s[54:55]
    s_waitcnt vmcnt(6)
    s_cbranch_scc1 L_w1
    s_waitcnt vmcnt(5)
    s_bitcmp1_b32 s3, 1
    s_cbranch_scc1 L_wb1
    s_waitcnt vmcnt(4)
L_wb1:
    s_cmp_lg_u32 s2, s2
L_w1:
    buffer_load_dwordx4 v[80:83], v1, s[8:11], s39 offen offset:0 nt
    v_mfma_f32_16x16x32_bf16 v[48:51], v[84:87], v[24:27], 0
    v_mfma_f32_16x16x32_bf16 v[52:55], v[84:87], v[28:31], 0
    v_mov_b32 v57, v14
    v_mov_b32 v61, v16
    v_cmp_gt_u32 s[52:53], s40, v11
    v_cmp_gt_u32 s[54:55], s41, v11
    s_nop 2
    v_fmac_f32_dpp v57, v48, v8 quad_perm:[0,0,0,0] row_mask:0xf bank_mask:0xf
    v_fmac_f32_dpp v61, v52, v8 quad_perm:[0,0,0,0] row_mask:0xf bank_mask:0xf
    s_nop 0
    v_fmac_f32_dpp v57, v49, v8 quad_perm:[1,1,1,1] row_mask:0xf bank_mask:0xf
    v_fmac_f32_dpp v61, v53, v8 quad_perm:[1,1,1,1] row_mask:0xf bank_mask:0xf
    s_nop 0
    v_fmac_f32_dpp v57, v50, v8 quad_perm:[2,2,2,2] row_mask:0xf bank_mask:0xf
    v_fmac_f32_dpp v61, v54, v8 quad_perm:[2,2,2,2] row_mask:0xf bank_mask:0xf
    s_nop 0
    v_fmac_f32_dpp v57, v51, v8 quad_perm:[3,3,3,3] row_mask:0xf bank_mask:0xf
    v_fmac_f32_dpp v61, v55, v8 quad_perm:[3,3,3,3] row_mask:0xf bank_mask:0xf
    v_cndmask_b32 v57, v9, v57, s[52:53]
    v_cndmask_b32 v61, v9, v61, s[54:55]
    s_waitcnt vmcnt(6)
    s_cbranch_scc1 L_w2
    s_waitcnt vmcnt(5)
    s_bitcmp1_b32 s3, 2
    s_cbranch_scc1 L_wb2
    s_waitcnt vmcnt(4)
L_wb2:
    s_cmp_lg_u32 s2, s2
L_w2:
    buffer_load_dwordx4 v[84:87], v1, s[8:11], s39 offen offset:2048 nt
    s_cbranch_scc1 L_ticket
L_tick_done:
    v_mfma_f32_16x16x32_bf16 v[48:51], v[88:91], v[24:27], 0
    v_mfma_f32_16x16x32_bf16 v[52:55], v[88:91], v[28:31], 0
    v_mov_b32 v58, v14
    v_mov_b32 v62, v16
    v_cmp_gt_u32 s[52:53], s40, v12
    v_cmp_gt_u32 s[54:55], s41, v12
    s_nop 2
    v_fmac_f32_dpp v58, v48, v8 quad_perm:[0,0,0,0] row_mask:0xf bank_mask:0xf
    v_fmac_f32_dpp v62, v52, v8 quad_perm:[0,0,0,0] row_mask:0xf bank_mask:0xf
    s_nop 0
    v_fmac_f32_dpp v58, v49, v8 quad_perm:[1,1,1,1] row_mask:0xf bank_mask:0xf
    v_fmac_f32_dpp v62, v53, v8 quad_perm:[1,1,1,1] row_mask:0xf bank_mask:0xf
    s_nop 0
    v_fmac_f32_dpp v58, v50, v8 quad_perm:[2,2,2,2] row_mask:0xf bank_mask:0xf
    v_fmac_f32_dpp v62, v54, v8 quad_perm:[2,2,2,2] row_mask:0xf bank_mask:0xf
    s_nop 0
    v_fmac_f32_dpp v58, v51, v8 quad_perm:[3,3,3,3] row_mask:0xf bank_mask:0xf
    v_fmac_f32_dpp v62, v55, v8 quad_perm:[3,3,3,3] row_mask:0xf bank_mask:0xf
    v_cndmask_b32 v58, v9, v58, s[52:53]
    v_cndmask_b32 v62, v9, v62, s[54:55]
    s_waitcnt vmcnt(7)
    s_cbranch_scc1 L_w3
    s_waitcnt vmcnt(5)
    s_bitcmp1_b32 s3, 3
    s_cbranch_scc1 L_wb3
    s_waitcnt vmcnt(4)
L_wb3:
    s_cmp_lg_u32 s2, s2
L_w3:
    buffer_load_dwordx4 v[88:91], v2, s[8:11], s39 offen offset:0 nt
    v_mfma_f32_16x16x32_bf16 v[48:51], v[92:95], v[24:27], 0
    v_mfma_f32_16x16x32_bf16 v[52:55], v[92:95], v[28:31], 0
    v_mov_b32 v59, v14
    v_mov_b32 v63, v16
    v_cmp_gt_u32 s[52:53], s40, v13
    v_cmp_gt_u32 s[54:55], s41, v13
    s_nop 2
    v_fmac_f32_dpp v59, v48, v8 quad_perm:[0,0,0,0] row_mask:0xf bank_mask:0xf
    v_fmac_f32_dpp v63, v52, v8 quad_perm:[0,0,0,0] row_mask:0xf bank_mask:0xf
    s_nop 0
    v_fmac_f32_dpp v59, v49, v8 quad_perm:[1,1,1,1] row_mask:0xf bank_mask:0xf
    v_fmac_f32_dpp v63, v53, v8 quad_perm:[1,1,1,1] row_mask:0xf bank_mask:0xf
    s_nop 0
    v_fmac_f32_dpp v59, v50, v8 quad_perm:[2,2,2,2] row_mask:0xf bank_mask:0xf
    v_fmac_f32_dpp v63, v54, v8 quad_perm:[2,2,2,2] row_mask:0xf bank_mask:0xf
    s_nop 0
    v_fmac_f32_dpp v59, v51, v8 quad_perm:[3,3,3,3] row_mask:0xf bank_mask:0xf
    v_fmac_f32_dpp v63, v55, v8 quad_perm:[3,3,3,3] row_mask:0xf bank_mask:0xf
    v_cndmask_b32 v59, v9, v59, s[52:53]
    v_cndmask_b32 v63, v9, v63, s[54:55]
    v_max3_f32 v18, v56, v57, v58
    v_max_f32 v18, v18, v59
    v_cmp_lt_f32 vcc, s48, v18
    s_cbranch_vccnz L_slow0
L_back0:
    v_exp_f32 v56, v56
    v_exp_f32 v57, v57
    v_exp_f32 v58, v58
    v_exp_f32 v59, v59
    v_add_f32 v20, v56, v57
    v_add_f32 v21, v58, v59
    v_cvt_pk_bf16_f32 v56, v56, v56
    v_cvt_pk_bf16_f32 v57, v57, v57
    v_cvt_pk_bf16_f32 v58, v58, v58
    v_cvt_pk_bf16_f32 v59, v59, v59
    v_add_f32 v20, v20, v21
    v_and_b32 v64, v56, v5
    v_and_b32 v65, v56, v6
    v_and_b32 v66, v57, v5
    v_and_b32 v67, v57, v6
    v_and_b32 v68, v58, v5
    v_and_b32 v69, v58, v6
    v_and_b32 v70, v59, v5
    v_and_b32 v71, v59, v6
    v_add_f32 v15, v15, v20
    s_waitcnt vmcnt(7)
    s_cbranch_scc1 L_w4
    s_waitcnt vmcnt(5)
    s_bitcmp1_b32 s3, 4
    s_cbranch_scc1 L_wb4
    s_waitcnt vmcnt(4)
L_wb4:
    s_cmp_lg_u32 s2, s2
L_w4:
    buffer_load_dwordx4 v[92:95], v2, s[8:11], s39 offen offset:2048 nt
    v_mfma_f32_16x16x16_bf16 v[32:35], v[96:97], v[64:65], v[32:35]
    v_mfma_f32_16x16x16_bf16 v[36:39], v[98:99], v[64:65], v[36:39]
    v_max3_f32 v18, v60, v61, v62
    v_max_f32 v18, v18, v63
    v_cmp_lt_f32 vcc, s49, v18
    s_cbranch_vccnz L_slow1
L_back1:
    v_exp_f32 v60, v60
    v_exp_f32 v61, v61
    v_exp_f32 v62, v62
    v_exp_f32 v63, v63
    v_add_f32 v20, v60, v61
    v_add_f32 v21, v62, v63
    v_cvt_pk_bf16_f32 v60, v60, v60
    v_cvt_pk_bf16_f32 v61, v61, v61
    v_cvt_pk_bf16_f32 v62, v62, v62
    v_cvt_pk_bf16_f32 v63, v63, v63
    v_add_f32 v20, v20, v21
    v_and_b32 v72, v60, v5
    v_and_b32 v73, v60, v6
    v_and_b32 v74, v61, v5
    v_and_b32 v75, v61, v6
    v_and_b32 v76, v62, v5
    v_and_b32 v77, v62, v6
    v_and_b32 v78, v63, v5
    v_and_b32 v79, v63, v6
    v_add_f32 v17, v17, v20
    s_nop 0
    v_mfma_f32_16x16x16_bf16 v[40:43], v[96:97], v[72:73], v[40:43]
    v_mfma_f32_16x16x16_bf16 v[44:47], v[98:99], v[72:73], v[44:47]
    s_waitcnt vmcnt(7)
    s_cbranch_scc1 L_w5
    s_waitcnt vmcnt(5)
    s_bitcmp1_b32 s3, 5
    s_cbranch_scc1 L_wb5
    s_waitcnt vmcnt(4)
L_wb5:
    s_cmp_lg_u32 s2, s2
L_w5:
    buffer_load_dwordx4 v[96:99], v3, s[12:15], s39 offen offset:0 nt
    v_mfma_f32_16x16x16_bf16 v[32:35], v[100:101], v[66:67], v[32:35]
    v_mfma_f32_16x16x16_bf16 v[36:39], v[102:103], v[66:67], v[36:39]
    v_mfma_f32_16x16x16_bf16 v[40:43], v[100:101], v[74:75], v[40:43]
    v_mfma_f32_16x16x16_bf16 v[44:47], v[102:103], v[74:75], v[44:47]
    s_waitcnt vmcnt(7)
    s_cbranch_scc1 L_w6
    s_waitcnt vmcnt(5)
    s_bitcmp1_b32 s3, 6
    s_cbranch_scc1 L_wb6
    s_waitcnt vmcnt(4)
L_wb6:
    s_cmp_lg_u32 s2, s2
L_w6:
    buffer_load_dwordx4 v[100:103], v3, s[12:15], s39 offen offset:2048 nt
    v_mfma_f32_16x16x16_bf16 v[32:35], v[104:105], v[68:69], v[32:35]
    v_mfma_f32_16x16x16_bf16 v[36:39], v[106:107], v[68:69], v[36:39]
    v_mfma_f32_16x16x16_bf16 v[40:43], v[104:105], v[76:77], v[40:43]
    v_mfma_f32_16x16x16_bf16 v[44:47], v[106:107], v[76:77], v[44:47]
    s_waitcnt vmcnt(7)
    s_cbranch_scc1 L_w7
    s_waitcnt vmcnt(5)
    s_bitcmp1_b32 s3, 7
    s_cbranch_scc1 L_wb7
    s_waitcnt vmcnt(4)
L_wb7:
    s_cmp_lg_u32 s2, s2
L_w7:
    buffer_load_dwordx4 v[104:107], v4, s[12:15], s39 offen offset:0 nt
    v_mfma_f32_16x16x16_bf16 v[32:35], v[108:109], v[70:71], v[32:35]
    v_mfma_f32_16x16x16_bf16 v[36:39], v[110:111], v[70:71], v[36:39]
    v_mfma_f32_16x16x16_bf16 v[40:43], v[108:109], v[78:79], v[40:43]
    v_mfma_f32_16x16x16_bf16 v[44:47], v[110:111], v[78:79], v[44:47]
    s_cmp_lg_u32 s42, 0
    s_cbranch_scc1 L_body
L_done:
    v_permlane32_swap_b32 v15, v17
    s_cmp_eq_u32 s50, 0
    s_cselect_b32 s43, 0, 0xf149f2ca
    v_add_f32 v15, v15, v17
    v_sub_f32 v14, s43, v14
    s_cmp_eq_u32 s51, 0
    s_cselect_b32 s44, 0, 0xf149f2ca
    v_sub_f32 v16, s44, v16
    v_mov_b32 v18, v15
    ds_write_b128 v115, v[32:35]
    ds_write_b128 v116, v[36:39]
    v_permlane16_swap_b32 v15, v18
    v_permlane32_swap_b32 v14, v16
    ds_write_b128 v115, v[40:43] offset:2048
    ds_write_b128 v116, v[44:47] offset:2048
    v_add_f32 v15, v15, v18
    ds_write_b64 v117, v[14:15] offset:16896
    s_waitcnt lgkmcnt(0)
    s_barrier
    ds_read_b128 v[68:71], v118 offset:16896
    ds_read_b128 v[72:75], v118 offset:16912
    ds_read_b128 v[48:51], v119 offset:0
    ds_read_b128 v[52:55], v119 offset:4096
    ds_read_b128 v[56:59], v119 offset:8192
    ds_read_b128 v[60:63], v119 offset:12288
    ds_read_b128 v[24:27], v123 offset:16896
    ds_read_b128 v[28:31], v123 offset:16912
    s_waitcnt lgkmcnt(6)
    v_max3_f32 v14, v68, v70, v72
    v_max_f32 v14, v14, v74
    v_sub_f32 v68, v68, v14
    v_sub_f32 v70, v70, v14
    v_sub_f32 v72, v72, v14
    v_sub_f32 v74, v74, v14
    v_exp_f32 v68, v68
    v_exp_f32 v70, v70
    v_exp_f32 v72, v72
    v_exp_f32 v74, v74
    v_mul_f32 v15, v68, v69
    v_fmac_f32 v15, v70, v71
    v_fmac_f32 v15, v72, v73
    v_fmac_f32 v15, v74, v75
    v_max_f32 v15, 0xda24260, v15
    v_rcp_f32 v12, v15
    v_log_f32 v15, v15
    s_waitcnt lgkmcnt(2)
    v_pk_mul_f32 v[64:65], v[48:49], v[68:69] op_sel_hi:[1,0]
    v_pk_mul_f32 v[66:67], v[50:51], v[68:69] op_sel_hi:[1,0]
    v_add_f32 v14, v14, v15
    v_pk_fma_f32 v[64:65], v[52:53], v[70:71], v[64:65] op_sel_hi:[1,0,1]
    v_pk_fma_f32 v[66:67], v[54:55], v[70:71], v[66:67] op_sel_hi:[1,0,1]
    v_pk_fma_f32 v[64:65], v[56:57], v[72:73], v[64:65] op_sel_hi:[1,0,1]
    v_pk_fma_f32 v[66:67], v[58:59], v[72:73], v[66:67] op_sel_hi:[1,0,1]
    v_pk_fma_f32 v[64:65], v[60:61], v[74:75], v[64:65] op_sel_hi:[1,0,1]
    v_pk_fma_f32 v[66:67], v[62:63], v[74:75], v[66:67] op_sel_hi:[1,0,1]
    v_pk_mul_f32 v[64:65], v[64:65], v[12:13] op_sel_hi:[1,0]
    v_pk_mul_f32 v[66:67], v[66:67], v[12:13] op_sel_hi:[1,0]
    v_min_u32 v13, -2, v14
    v_cvt_pk_bf16_f32 v64, v64, v65
    v_cvt_pk_bf16_f32 v65, v66, v67
    v_min_u32 v64, -2, v64
    v_min_u32 v65, -2, v65
    s_cmp_eq_u32 s77, 2
    s_cbranch_scc0 L_far
    buffer_store_dwordx2 v[64:65], v120, s[24:27], s74 offen
    buffer_store_dword v13, v124, s[24:27], s70 offen offset:2048
L_stored:
    s_mov_b32 s44, 0x80000
    s_mov_b32 s60, 0xffff0000
    s_mov_b32 s62, 0x4e800000
    s_mov_b32 s68, 0x00030003
    s_mov_b32 s69, 0x00030003
    s_waitcnt lgkmcnt(0)
    v_max3_f32 v24, v24, v26, v28
    v_max_f32 v24, v24, v30
L_mpoll:
    buffer_load_dwordx2 v[44:45], v121, s[24:27], s75 offen sc1
    buffer_load_dword v14, v125, s[24:27], s75 offen sc1
    s_sub_u32 s44, s44, 1
    s_cbranch_scc1 L_mhave
    s_waitcnt vmcnt(0)
    v_max3_u32 v8, v44, v45, v14
    v_cmpx_eq_u32 vcc, -1, v8
    s_cbranch_execnz L_mpoll
L_mhave:
    s_mov_b64 exec, -1
L_mred:
    v_sub_f32 v40, v14, v24
    v_exp_f32 v40, v40
    v_lshlrev_b32 v32, 16, v44
    v_and_b32 v33, s60, v44
    v_lshlrev_b32 v34, 16, v45
    v_and_b32 v35, s60, v45
    v_pk_mul_f32 v[36:37], v[32:33], v[40:41] op_sel_hi:[1,0]
    v_pk_mul_f32 v[38:39], v[34:35], v[40:41] op_sel_hi:[1,0]
    v_mov_b32 v9, v40
    s_nop 0
    v_permlane32_swap_b32 v36, v38
    v_permlane32_swap_b32 v37, v39
    v_permlane32_swap_b32 v40, v9
    v_add_f32 v36, v36, v38
    v_add_f32 v37, v37, v39
    v_add_f32 v40, v40, v9
    v_mov_b32 v9, v40
    v_permlane16_swap_b32 v36, v37
    s_nop 0
    v_permlane16_swap_b32 v40, v9
    v_add_f32 v36, v36, v37
    s_nop 0
    v_add_f32 v40, v40, v9
    v_add_f32_dpp v36, v36, v36 row_ror:8 row_mask:0xf bank_mask:0xf
    s_nop 0
    v_add_f32_dpp v40, v40, v40 row_ror:8 row_mask:0xf bank_mask:0xf
    v_add_f32_dpp v36, v36, v36 row_ror:4 row_mask:0xf bank_mask:0xf
    s_nop 0
    v_add_f32_dpp v40, v40, v40 row_ror:4 row_mask:0xf bank_mask:0xf
    v_add_f32_dpp v36, v36, v36 row_ror:2 row_mask:0xf bank_mask:0xf
    s_nop 0
    v_add_f32_dpp v40, v40, v40 row_ror:2 row_mask:0xf bank_mask:0xf
    v_rcp_f32 v9, v40
    v_cmp_lt_f32 vcc, s62, v40
    v_mul_f32 v36, v36, v9
    s_cbranch_vccnz L_mfall
    s_mov_b64 exec, s[68:69]
    v_cvt_pk_bf16_f32 v36, v36, v36
    buffer_store_short v36, v122, s[64:67], s76 offen
    s_endpgm
L_far:
    buffer_store_dwordx2 v[64:65], v120, s[24:27], s74 offen sc1
    buffer_store_dword v13, v124, s[24:27], s70 offen offset:2048 sc1
    s_branch L_stored
L_none:
    s_waitcnt vmcnt(0)
    s_branch L_done
L_mfall:
    s_mov_b32 s62, 0x7f800000
    v_mov_b32 v24, v14
    s_nop 1
    v_max_f32_dpp v24, v24, v24 row_ror:8 row_mask:0xf bank_mask:0xf
    s_nop 1
    v_max_f32_dpp v24, v24, v24 row_ror:4 row_mask:0xf bank_mask:0xf
    s_nop 1
    v_max_f32_dpp v24, v24, v24 row_ror:2 row_mask:0xf bank_mask:0xf
    v_mov_b32 v9, v24
    s_nop 1
    v_permlane16_swap_b32 v24, v9
    s_nop 1
    v_max_f32 v24, v24, v9
    v_mov_b32 v9, v24
    s_nop 1
    v_permlane32_swap_b32 v24, v9
    s_nop 1
    v_max_f32 v24, v24, v9
    s_branch L_mred
L_service:
    s_load_dwordx2 s[4:5], s[0:1], 48
    v_mov_b32 v2, 0
    v_mov_b32 v3, 0
    ds_write_b64 v2, v[2:3] offset:18432
    ds_write_b64 v2, v[2:3] offset:18440
    ds_write_b32 v2, v2 offset:18448
    s_mov_b32 s6, 256
    s_mov_b32 s7, 0x20000
    s_lshl_b32 s40, s32, 5
    s_add_u32 s40, s40, s33
    s_lshl_b32 s40, s40, 12
    s_and_b32 s41, s33, 15
    s_lshl_b32 s41, s41, 7
    s_add_u32 s41, s41, s40
    s_lshl_b32 s42, s32, 5
    s_lshr_b32 s61, s2, 3
    s_lshl_b32 s61, s61, 8
    s_add_u32 s61, s61, 0x200000
    v_lshlrev_b32 v1, 4, v0
    v_mov_b32 v4, -1
    v_mov_b32 v5, -1
    v_mov_b32 v6, -1
    v_mov_b32 v7, -1
    s_waitcnt lgkmcnt(0)
    s_barrier
    s_load_dwordx2 s[30:31], s[28:29], 0
    buffer_store_dwordx4 v[4:7], v1, s[24:27], s40 offen offset:0 sc1
    buffer_store_dwordx4 v[4:7], v1, s[24:27], s40 offen offset:1024 sc1
    s_mov_b64 exec, 0xff
    buffer_store_dwordx4 v[4:7], v1, s[24:27], s41 offen offset:2048 sc1
    s_mov_b64 exec, -1
    s_and_b32 s43, s2, 7
    s_cbranch_scc1 L_nolead
    v_lshlrev_b32 v20, 2, v0
    buffer_store_dword v2, v20, s[24:27], s61 offen sc1
L_nolead:
    s_waitcnt lgkmcnt(0)
    s_cmp_lt_i32 s30, 1
    s_cselect_b32 s30, 0x8000, s30
    s_min_u32 s30, s30, 0x8000
    s_cmp_lt_i32 s31, 1
    s_cselect_b32 s31, 0x8000, s31
    s_min_u32 s31, s31, 0x8000
    s_and_b32 s62, s30, 0xf800
    s_and_b32 s63, s31, 0xf800
    s_add_u32 s43, s30, s31
    s_sub_u32 s43, s43, s62
    s_sub_u32 s43, s43, s63
    s_cmp_lt_u32 s43, 2048
    s_cselect_b32 s43, 2048, 0
    s_cmp_lt_u32 s62, s63
    s_cselect_b32 s44, 0, s43
    s_cselect_b32 s43, s43, 0
    s_sub_i32 s62, s62, s44
    s_sub_i32 s63, s63, s43
    s_max_i32 s43, s62, s63
    s_cmp_lt_i32 s43, 4096
    s_cselect_b32 s62, 0x8000, s62
    s_cselect_b32 s63, 0x8000, s63
    s_add_u32 s43, s30, 15
    s_sub_i32 s43, s43, s62
    s_ashr_i32 s43, s43, 4
    s_max_i32 s43, s43, 0
    s_lshr_b32 s62, s62, 4
    s_lshr_b32 s63, s63, 4
    s_sub_i32 s63, s63, s43
    v_mov_b32 v8, s62
    v_mov_b32 v9, s63
    v_mov_b32 v10, s30
    v_mov_b32 v11, s31
    v_add_u32 v32, 0, v0
    v_add_u32 v33, 64, v0
    v_add_u32 v34, 128, v0
    v_add_u32 v35, 192, v0
    v_add_u32 v36, 256, v0
    v_cmp_le_u32 vcc, s43, v32
    s_nop 1
    v_cndmask_b32 v40, v8, v9, vcc
    v_cndmask_b32 v48, v10, v11, vcc
    v_cndmask_b32 v56, 0, 1, vcc
    v_add_u32 v40, v40, v32
    v_lshlrev_b32 v32, 4, v40
    v_sub_u32 v48, v48, v32
    v_med3_i32 v48, v48, 0, 16
    v_mul_u32_u24 v32, 5, v56
    v_lshlrev_b32 v48, v32, v48
    v_lshlrev_b32 v40, 2, v40
    v_lshl_add_u32 v40, v56, 13, v40
    buffer_load_dword v56, v40, s[20:23], 0 offen
    v_cmp_le_u32 vcc, s43, v33
    s_nop 1
    v_cndmask_b32 v41, v8, v9, vcc
    v_cndmask_b32 v49, v10, v11, vcc
    v_cndmask_b32 v57, 0, 1, vcc
    v_add_u32 v41, v41, v33
    v_lshlrev_b32 v33, 4, v41
    v_sub_u32 v49, v49, v33
    v_med3_i32 v49, v49, 0, 16
    v_mul_u32_u24 v33, 5, v57
    v_lshlrev_b32 v49, v33, v49
    v_lshlrev_b32 v41, 2, v41
    v_lshl_add_u32 v41, v57, 13, v41
    buffer_load_dword v57, v41, s[20:23], 0 offen
    v_cmp_le_u32 vcc, s43, v34
    s_nop 1
    v_cndmask_b32 v42, v8, v9, vcc
    v_cndmask_b32 v50, v10, v11, vcc
    v_cndmask_b32 v58, 0, 1, vcc
    v_add_u32 v42, v42, v34
    v_lshlrev_b32 v34, 4, v42
    v_sub_u32 v50, v50, v34
    v_med3_i32 v50, v50, 0, 16
    v_mul_u32_u24 v34, 5, v58
    v_lshlrev_b32 v50, v34, v50
    v_lshlrev_b32 v42, 2, v42
    v_lshl_add_u32 v42, v58, 13, v42
    buffer_load_dword v58, v42, s[20:23], 0 offen
    v_cmp_le_u32 vcc, s43, v35
    s_nop 1
    v_cndmask_b32 v43, v8, v9, vcc
    v_cndmask_b32 v51, v10, v11, vcc
    v_cndmask_b32 v59, 0, 1, vcc
    v_add_u32 v43, v43, v35
    v_lshlrev_b32 v35, 4, v43
    v_sub_u32 v51, v51, v35
    v_med3_i32 v51, v51, 0, 16
    v_mul_u32_u24 v35, 5, v59
    v_lshlrev_b32 v51, v35, v51
    v_lshlrev_b32 v43, 2, v43
    v_lshl_add_u32 v43, v59, 13, v43
    buffer_load_dword v59, v43, s[20:23], 0 offen
    v_cmp_le_u32 vcc, s43, v36
    s_nop 1
    v_cndmask_b32 v44, v8, v9, vcc
    v_cndmask_b32 v52, v10, v11, vcc
    v_cndmask_b32 v60, 0, 1, vcc
    v_add_u32 v44, v44, v36
    v_lshlrev_b32 v36, 4, v44
    v_sub_u32 v52, v52, v36
    v_med3_i32 v52, v52, 0, 16
    v_mul_u32_u24 v36, 5, v60
    v_lshlrev_b32 v52, v36, v52
    v_lshlrev_b32 v44, 2, v44
    v_lshl_add_u32 v44, v60, 13, v44
    buffer_load_dword v60, v44, s[20:23], 0 offen
    v_lshlrev_b32 v20, 2, v0
    s_getreg_b32 s47, hwreg(HW_REG_XCC_ID, 0, 3)
    s_lshl_b32 s47, s47, 3
    s_lshl_b64 s[58:59], 1, s47
    v_mov_b32 v12, s58
    v_mov_b32 v13, s59
    v_lshlrev_b32 v14, 5, v0
    s_waitcnt vmcnt(0)
    s_mov_b64 exec, 1
    buffer_atomic_add_x2 v[12:13], v2, s[4:7], s42 offen sc1
    s_mov_b64 exec, -1
    v_min_u32 v56, 3071, v56
    v_cmp_ne_u32 vcc, 0, v48
    v_lshl_or_b32 v56, v56, 15, v48
    s_nop 0
    v_cndmask_b32 v56, 0, v56, vcc
    ds_write_b32 v20, v56 offset:17152
    v_min_u32 v57, 3071, v57
    v_cmp_ne_u32 vcc, 0, v49
    v_lshl_or_b32 v57, v57, 15, v49
    s_nop 0
    v_cndmask_b32 v57, 0, v57, vcc
    ds_write_b32 v20, v57 offset:17408
    v_min_u32 v58, 3071, v58
    v_cmp_ne_u32 vcc, 0, v50
    v_lshl_or_b32 v58, v58, 15, v50
    s_nop 0
    v_cndmask_b32 v58, 0, v58, vcc
    ds_write_b32 v20, v58 offset:17664
    v_min_u32 v59, 3071, v59
    v_cmp_ne_u32 vcc, 0, v51
    v_lshl_or_b32 v59, v59, 15, v51
    s_nop 0
    v_cndmask_b32 v59, 0, v59, vcc
    ds_write_b32 v20, v59 offset:17920
    v_min_u32 v60, 3071, v60
    v_cmp_ne_u32 vcc, 0, v52
    v_lshl_or_b32 v60, v60, 15, v52
    s_nop 0
    v_cndmask_b32 v60, 0, v60, vcc
    ds_write_b32 v20, v60 offset:18176
    s_mov_b32 s44, 0x10000
    s_mov_b64 exec, 0xff
    s_sleep 100
    buffer_load_dwordx2 v[8:9], v14, s[4:7], 0 offen
    s_branch L_rdy_chk
L_rdy:
    s_sleep 127
    buffer_load_dwordx2 v[8:9], v14, s[4:7], 0 offen sc1
L_rdy_chk:
    s_waitcnt vmcnt(0)
    v_add_u32 v10, v8, v9
    v_sad_u8 v10, v10, 0, 0
    v_cmp_gt_u32 vcc, 32, v10
    s_cbranch_vccz L_rdy_ok
    s_sub_u32 s44, s44, 1
    s_cbranch_scc0 L_rdy
L_rdy_ok:
    v_readlane_b32 s58, v8, s32
    v_readlane_b32 s59, v9, s32
    s_lshr_b64 s[58:59], s[58:59], s47
    s_and_b32 s58, s58, 0xff
    s_cmp_eq_u32 s58, 32
    s_cselect_b32 s43, 2, 1
    v_mov_b32 v3, s43
    s_waitcnt lgkmcnt(0)
    ds_write_b32 v2, v3 offset:18448
    s_mov_b64 exec, -1
    s_waitcnt lgkmcnt(0)
    s_barrier
L_end:
    s_endpgm
.section .rodata,"a"
.p2align 6
.amdhsa_kernel standalone__paged_block_table_kv_radixattention__decode_kernel
  .amdhsa_next_free_vgpr 128
  .amdhsa_next_free_sgpr 78
  .amdhsa_accum_offset 128
  .amdhsa_group_segment_fixed_size 0
  .amdhsa_kernarg_size 64
  .amdhsa_user_sgpr_count 2
  .amdhsa_user_sgpr_kernarg_segment_ptr 1
  .amdhsa_system_sgpr_workgroup_id_x 1
.end_amdhsa_kernel
```
